```python
import torch

def _softmax(x, axis=-1):
    return torch.softmax(x, dim=axis)
def _gelu(x):
    return torch.nn.functional.gelu(x, approximate="tanh")
def _silu(x):
    return torch.nn.functional.silu(x)
def _sigmoid(x):
    return torch.sigmoid(x)
def _layernorm(x, axis=-1, eps=1e-5):
    m = x.mean(dim=axis, keepdim=True)
    v = x.var(dim=axis, keepdim=True, unbiased=False)
    return (x - m) / torch.sqrt(v + eps)
def _scatter_add(tgt, idx, src, axis=0):
    return tgt.clone().index_add_(axis, idx, src)
def _segment_sum(src, seg, n):
    out = torch.zeros((n,) + src.shape[1:], dtype=src.dtype)
    return out.index_add_(0, seg, src)
def _pad(x, pw):
    flat = tuple(v for pair in reversed(pw) for v in pair)
    return torch.nn.functional.pad(x, flat)

kernel_name = 'standalone__geglu_ffn__sampling'

def setup_inputs():

    _w = (lambda a: (lambda t: t.to(torch.bfloat16) if t.is_floating_point() else t)(torch.as_tensor(a)))
    B, S, D, F = 8, 8, 1024, 3584
    return {
        "x": _w((lambda *s: torch.randn(*s, dtype=torch.bfloat16) * 0.05)(B, S, D)),
        "w_gate": _w((lambda *s: torch.randn(*s, dtype=torch.bfloat16) * 0.05)(D, F)),
        "w_up": _w((lambda *s: torch.randn(*s, dtype=torch.bfloat16) * 0.05)(D, F)),
        "w_down": _w((lambda *s: torch.randn(*s, dtype=torch.bfloat16) * 0.05)(F, D)),
    }

def reference(x, w_gate, w_up, w_down):
    return (_gelu(x @ w_gate) * (x @ w_up)) @ w_down
```

```asm
; @launch kernel=standalone__geglu_ffn__sampling_kernel grid=(256,1,1) block=(768,1,1) lds=161792
.amdgcn_target "amdgcn-amd-amdhsa--gfx950"
.text
.globl standalone__geglu_ffn__sampling_kernel
.p2align 8
.type standalone__geglu_ffn__sampling_kernel,@function
standalone__geglu_ffn__sampling_kernel:
    s_load_dwordx8 s[4:11], s[0:1], 0
    s_load_dwordx4 s[12:15], s[0:1], 32
    s_load_dwordx2 s[16:17], s[0:1], 48
    s_cmp_ge_u32 s2, 256
    s_cbranch_scc1 L_end
    v_lshrrev_b32 v1, 6, v0
    v_and_b32 v2, 63, v0
    s_and_b32 s44, s2, 7
    v_readfirstlane_b32 s3, v1
    s_lshr_b32 s45, s2, 3
    v_lshrrev_b32 v5, 3, v2
    v_and_b32 v7, 7, v2
    s_mov_b32 s22, 7340032
    s_mov_b32 s23, 0x20000
    s_mov_b32 s26, 131072
    s_mov_b32 s27, 0x20000
    s_cmp_ge_u32 s3, 4
    s_cbranch_scc1 L_ids
    s_cmp_lt_u32 s45, 14
    s_cbranch_scc1 L_ids
    v_mul_u32_u24 v13, 7168, v5
    v_min_u32 v6, 6, v7
    v_lshlrev_b32 v6, 7, v6
    s_mul_i32 s53, s44, 896
    v_add3_u32 v13, v13, v6, s53
    s_mul_i32 s51, s3, 18
    s_add_u32 s51, s51, s45
    s_sub_u32 s51, s51, 14
    s_lshr_b32 s52, s51, 1
    s_mul_i32 s52, s52, 57344
    s_add_u32 s52, s52, 745472
    v_lshlrev_b32 v9, 11, v2
    s_sub_u32 s53, s45, 16
    s_lshl_b32 s53, s53, 7
    s_bitcmp1_b32 s51, 0
    s_waitcnt lgkmcnt(0)
    s_cselect_b32 s20, s8, s6
    s_cselect_b32 s21, s9, s7
    s_mov_b32 s24, s4
    s_mov_b32 s25, s5
    s_add_u32 s90, s16, 4194304
    s_addc_u32 s91, s17, 0
    s_load_dword s92, s[90:91], 0
    s_load_dword s93, s[14:15], 0
    s_cmp_lg_u32 s3, 0
    s_cbranch_scc1 L_nx
    s_cmp_lt_u32 s45, 16
    s_cbranch_scc1 L_tc
    buffer_load_dword v15, v9, s[24:27], s53 offen
    s_branch L_nx
    L_tc:
    s_getpc_b64 s[18:19]
    L_pc:
    s_sub_u32 s18, s18, L_pc-standalone__geglu_ffn__sampling_kernel
    s_subb_u32 s19, s19, 0
    v_lshlrev_b32 v9, 7, v2
    s_and_b32 s53, s45, 1
    s_lshl_b32 s53, s53, 13
    v_add_u32 v9, s53, v9
    v_min_u32 v9, L_end-standalone__geglu_ffn__sampling_kernel, v9
    global_load_dword v15, v9, s[18:19]
    s_lshl_b32 s53, s44, 7
    s_add_u32 s53, s53, 4202496
    v_mov_b32 v9, s53
    global_load_dword v15, v9, s[16:17]
    L_nx:
    s_add_u32 s58, s52, 0
    buffer_load_dword v15, v13, s[20:23], s58 offen
    s_barrier
    s_add_u32 s58, s52, 2064384
    buffer_load_dword v15, v13, s[20:23], s58 offen
    s_add_u32 s58, s52, 4128768
    buffer_load_dword v15, v13, s[20:23], s58 offen
    s_add_u32 s58, s52, 6193152
    s_cmp_ge_u32 s58, 7340032
    s_cbranch_scc1 L_ids
    buffer_load_dword v15, v13, s[20:23], s58 offen
    L_ids:
    s_and_b32 s48, s45, 7
    s_lshl_b32 s53, s48, 2
    s_lshr_b32 s48, 0x51743260, s53
    s_and_b32 s48, s48, 7
    s_lshr_b32 s49, s45, 3
    s_mov_b32 s47, 56774976
    s_cmp_ge_u32 s45, 14
    s_cselect_b32 s47, 17122866, s47
    s_cmp_ge_u32 s45, 16
    s_cselect_b32 s47, 106181136, s47
    s_cmp_ge_u32 s45, 24
    s_cselect_b32 s47, 52495956, s47
    v_lshrrev_b32 v3, 4, v2
    v_and_b32 v4, 15, v2
    s_cmp_ge_u32 s3, 4
    s_cbranch_scc1 L_compute
    s_lshl_b32 s55, s3, 10
    s_and_b32 s52, s3, 1
    s_cmp_ge_u32 s45, 14
    s_cbranch_scc1 L_ld_P
    s_lshl_b32 s51, s3, 3
    v_add_u32 v5, s51, v5
    v_mul_u32_u24 v10, 7168, v5
    v_and_b32 v6, 1, v3
    s_lshl_b32 s53, s52, 1
    v_or_b32 v6, s53, v6
    v_lshlrev_b32 v6, 1, v6
    v_xor_b32 v6, v6, v7
    v_lshlrev_b32 v6, 4, v6
    s_mul_i32 s53, s44, 7
    s_lshr_b32 s46, s45, 1
    s_add_u32 s53, s53, s46
    s_lshl_b32 s53, s53, 7
    v_add3_u32 v10, v10, v6, s53
    v_bfe_u32 v6, v5, 1, 3
    v_xor_b32 v6, v6, v7
    v_lshlrev_b32 v6, 4, v6
    v_lshlrev_b32 v5, 11, v5
    v_add_u32 v11, v5, v6
    s_bitcmp1_b32 s45, 0
    s_waitcnt lgkmcnt(0)
    s_cselect_b32 s20, s8, s6
    s_cselect_b32 s21, s9, s7
    s_mov_b32 s24, s4
    s_mov_b32 s25, s5
    s_setprio 2
    s_add_u32 m0, s55, 0
    s_mov_b32 s58, 0
    buffer_load_dwordx4 v10, s[20:23], s58 offen lds
    s_add_u32 s90, s16, 4194304
    s_addc_u32 s91, s17, 0
    s_load_dword s92, s[90:91], 0
    s_load_dword s93, s[14:15], 0
    s_add_u32 m0, s55, 8192
    s_mov_b32 s58, 0
    buffer_load_dwordx4 v11, s[24:27], s58 offen lds
    s_add_u32 m0, s55, 4096
    s_mov_b32 s58, 229376
    buffer_load_dwordx4 v10, s[20:23], s58 offen lds
    s_add_u32 m0, s55, 12288
    s_mov_b32 s58, 65536
    buffer_load_dwordx4 v11, s[24:27], s58 offen lds
    s_add_u32 m0, s55, 16384
    s_mov_b32 s58, 458752
    buffer_load_dwordx4 v10, s[20:23], s58 offen lds
    s_add_u32 m0, s55, 24576
    s_mov_b32 s58, 128
    buffer_load_dwordx4 v11, s[24:27], s58 offen lds
    s_add_u32 m0, s55, 20480
    s_mov_b32 s58, 688128
    buffer_load_dwordx4 v10, s[20:23], s58 offen lds
    s_add_u32 m0, s55, 28672
    s_mov_b32 s58, 65664
    buffer_load_dwordx4 v11, s[24:27], s58 offen lds
    s_add_u32 m0, s55, 32768
    s_mov_b32 s58, 917504
    buffer_load_dwordx4 v10, s[20:23], s58 offen lds
    s_add_u32 m0, s55, 40960
    s_mov_b32 s58, 256
    buffer_load_dwordx4 v11, s[24:27], s58 offen lds
    s_add_u32 m0, s55, 36864
    s_mov_b32 s58, 1146880
    buffer_load_dwordx4 v10, s[20:23], s58 offen lds
    s_add_u32 m0, s55, 45056
    s_mov_b32 s58, 65792
    buffer_load_dwordx4 v11, s[24:27], s58 offen lds
    s_add_u32 m0, s55, 49152
    s_mov_b32 s58, 1376256
    buffer_load_dwordx4 v10, s[20:23], s58 offen lds
    s_mov_b32 s28, s10
    s_mov_b32 s29, s11
    s_mov_b32 s30, 7340032
    s_mov_b32 s31, 0x20000
    s_lshl_b32 s53, s52, 2
    v_add_u32 v5, s53, v3
    v_lshlrev_b32 v5, 1, v5
    v_xor_b32 v6, v5, v4
    v_lshlrev_b32 v6, 4, v6
    s_mul_i32 s53, s44, 448
    s_lshl_b32 s54, s3, 2
    s_add_u32 s53, s53, s54
    v_add_u32 v5, s53, v3
    v_lshlrev_b32 v5, 11, v5
    s_lshl_b32 s53, s48, 8
    v_add3_u32 v12, v5, v6, s53
    s_waitcnt vmcnt(9)
    s_add_u32 m0, s55, 57344
    s_mov_b32 s58, 384
    buffer_load_dwordx4 v11, s[24:27], s58 offen lds
    s_add_u32 m0, s55, 53248
    s_mov_b32 s58, 1605632
    buffer_load_dwordx4 v10, s[20:23], s58 offen lds
    s_add_u32 m0, s55, 61440
    s_mov_b32 s58, 65920
    buffer_load_dwordx4 v11, s[24:27], s58 offen lds
    s_barrier
    s_waitcnt vmcnt(8)
    s_add_u32 m0, s55, 65536
    s_mov_b32 s58, 1835008
    buffer_load_dwordx4 v10, s[20:23], s58 offen lds
    s_add_u32 m0, s55, 73728
    s_mov_b32 s58, 512
    buffer_load_dwordx4 v11, s[24:27], s58 offen lds
    s_add_u32 m0, s55, 69632
    s_mov_b32 s58, 2064384
    buffer_load_dwordx4 v10, s[20:23], s58 offen lds
    s_add_u32 m0, s55, 77824
    s_mov_b32 s58, 66048
    buffer_load_dwordx4 v11, s[24:27], s58 offen lds
    s_barrier
    s_waitcnt vmcnt(8)
    s_add_u32 m0, s55, 81920
    s_mov_b32 s58, 2293760
    buffer_load_dwordx4 v10, s[20:23], s58 offen lds
    s_add_u32 m0, s55, 90112
    s_mov_b32 s58, 640
    buffer_load_dwordx4 v11, s[24:27], s58 offen lds
    s_add_u32 m0, s55, 86016
    s_mov_b32 s58, 2523136
    buffer_load_dwordx4 v10, s[20:23], s58 offen lds
    s_add_u32 m0, s55, 94208
    s_mov_b32 s58, 66176
    buffer_load_dwordx4 v11, s[24:27], s58 offen lds
    s_barrier
    s_waitcnt vmcnt(8)
    s_add_u32 m0, s55, 98304
    s_mov_b32 s58, 2752512
    buffer_load_dwordx4 v10, s[20:23], s58 offen lds
    s_add_u32 m0, s55, 106496
    s_mov_b32 s58, 768
    buffer_load_dwordx4 v11, s[24:27], s58 offen lds
    s_add_u32 m0, s55, 102400
    s_mov_b32 s58, 2981888
    buffer_load_dwordx4 v10, s[20:23], s58 offen lds
    s_add_u32 m0, s55, 110592
    s_mov_b32 s58, 66304
    buffer_load_dwordx4 v11, s[24:27], s58 offen lds
    s_barrier
    s_waitcnt vmcnt(8)
    s_add_u32 m0, s55, 114688
    s_mov_b32 s58, 3211264
    buffer_load_dwordx4 v10, s[20:23], s58 offen lds
    s_add_u32 m0, s55, 122880
    s_mov_b32 s58, 896
    buffer_load_dwordx4 v11, s[24:27], s58 offen lds
    s_add_u32 m0, s55, 118784
    s_mov_b32 s58, 3440640
    buffer_load_dwordx4 v10, s[20:23], s58 offen lds
    s_add_u32 m0, s55, 126976
    s_mov_b32 s58, 66432
    buffer_load_dwordx4 v11, s[24:27], s58 offen lds
    s_barrier
    s_waitcnt vmcnt(8)
    s_add_u32 m0, s55, 131072
    s_mov_b32 s58, 3670016
    buffer_load_dwordx4 v10, s[20:23], s58 offen lds
    s_add_u32 m0, s55, 139264
    s_mov_b32 s58, 1024
    buffer_load_dwordx4 v11, s[24:27], s58 offen lds
    s_add_u32 m0, s55, 135168
    s_mov_b32 s58, 3899392
    buffer_load_dwordx4 v10, s[20:23], s58 offen lds
    s_add_u32 m0, s55, 143360
    s_mov_b32 s58, 66560
    buffer_load_dwordx4 v11, s[24:27], s58 offen lds
    s_barrier
    s_waitcnt vmcnt(8)
    s_add_u32 m0, s55, 0
    s_mov_b32 s58, 4128768
    buffer_load_dwordx4 v10, s[20:23], s58 offen lds
    s_add_u32 m0, s55, 8192
    s_mov_b32 s58, 1152
    buffer_load_dwordx4 v11, s[24:27], s58 offen lds
    s_add_u32 m0, s55, 4096
    s_mov_b32 s58, 4358144
    buffer_load_dwordx4 v10, s[20:23], s58 offen lds
    s_add_u32 m0, s55, 12288
    s_mov_b32 s58, 66688
    buffer_load_dwordx4 v11, s[24:27], s58 offen lds
    s_barrier
    s_waitcnt vmcnt(8)
    s_add_u32 m0, s55, 16384
    s_mov_b32 s58, 4587520
    buffer_load_dwordx4 v10, s[20:23], s58 offen lds
    s_add_u32 m0, s55, 24576
    s_mov_b32 s58, 1280
    buffer_load_dwordx4 v11, s[24:27], s58 offen lds
    s_add_u32 m0, s55, 20480
    s_mov_b32 s58, 4816896
    buffer_load_dwordx4 v10, s[20:23], s58 offen lds
    s_add_u32 m0, s55, 28672
    s_mov_b32 s58, 66816
    buffer_load_dwordx4 v11, s[24:27], s58 offen lds
    s_barrier
    s_waitcnt vmcnt(8)
    s_add_u32 m0, s55, 32768
    s_mov_b32 s58, 5046272
    buffer_load_dwordx4 v10, s[20:23], s58 offen lds
    s_add_u32 m0, s55, 40960
    s_mov_b32 s58, 1408
    buffer_load_dwordx4 v11, s[24:27], s58 offen lds
    s_add_u32 m0, s55, 36864
    s_mov_b32 s58, 5275648
    buffer_load_dwordx4 v10, s[20:23], s58 offen lds
    s_add_u32 m0, s55, 45056
    s_mov_b32 s58, 66944
    buffer_load_dwordx4 v11, s[24:27], s58 offen lds
    s_barrier
    s_waitcnt vmcnt(8)
    s_add_u32 m0, s55, 49152
    s_mov_b32 s58, 5505024
    buffer_load_dwordx4 v10, s[20:23], s58 offen lds
    s_add_u32 m0, s55, 57344
    s_mov_b32 s58, 1536
    buffer_load_dwordx4 v11, s[24:27], s58 offen lds
    s_add_u32 m0, s55, 53248
    s_mov_b32 s58, 5734400
    buffer_load_dwordx4 v10, s[20:23], s58 offen lds
    s_add_u32 m0, s55, 61440
    s_mov_b32 s58, 67072
    buffer_load_dwordx4 v11, s[24:27], s58 offen lds
    s_barrier
    s_waitcnt vmcnt(8)
    s_add_u32 m0, s55, 65536
    s_mov_b32 s58, 5963776
    buffer_load_dwordx4 v10, s[20:23], s58 offen lds
    s_add_u32 m0, s55, 73728
    s_mov_b32 s58, 1664
    buffer_load_dwordx4 v11, s[24:27], s58 offen lds
    s_add_u32 m0, s55, 69632
    s_mov_b32 s58, 6193152
    buffer_load_dwordx4 v10, s[20:23], s58 offen lds
    s_add_u32 m0, s55, 77824
    s_mov_b32 s58, 67200
    buffer_load_dwordx4 v11, s[24:27], s58 offen lds
    s_barrier
    s_waitcnt vmcnt(8)
    s_add_u32 m0, s55, 81920
    s_mov_b32 s58, 6422528
    buffer_load_dwordx4 v10, s[20:23], s58 offen lds
    s_add_u32 m0, s55, 90112
    s_mov_b32 s58, 1792
    buffer_load_dwordx4 v11, s[24:27], s58 offen lds
    s_add_u32 m0, s55, 86016
    s_mov_b32 s58, 6651904
    buffer_load_dwordx4 v10, s[20:23], s58 offen lds
    s_add_u32 m0, s55, 94208
    s_mov_b32 s58, 67328
    buffer_load_dwordx4 v11, s[24:27], s58 offen lds
    s_barrier
    s_waitcnt vmcnt(8)
    s_add_u32 m0, s55, 98304
    s_mov_b32 s58, 6881280
    buffer_load_dwordx4 v10, s[20:23], s58 offen lds
    s_add_u32 m0, s55, 106496
    s_mov_b32 s58, 1920
    buffer_load_dwordx4 v11, s[24:27], s58 offen lds
    s_add_u32 m0, s55, 102400
    s_mov_b32 s58, 7110656
    buffer_load_dwordx4 v10, s[20:23], s58 offen lds
    s_add_u32 m0, s55, 110592
    s_mov_b32 s58, 67456
    buffer_load_dwordx4 v11, s[24:27], s58 offen lds
    s_barrier
    s_waitcnt vmcnt(8)
    s_barrier
    s_bfe_u32 s59, s47, 262144
    s_add_u32 m0, s55, 114688
    s_lshl_b32 s59, s59, 17
    buffer_load_dwordx4 v12, s[28:31], s59 offen lds
    s_add_u32 m0, s55, 118784
    s_add_u32 s59, s59, 32768
    buffer_load_dwordx4 v12, s[28:31], s59 offen lds
    s_add_u32 m0, s55, 122880
    s_add_u32 s59, s59, 32768
    buffer_load_dwordx4 v12, s[28:31], s59 offen lds
    s_add_u32 m0, s55, 126976
    s_add_u32 s59, s59, 32768
    buffer_load_dwordx4 v12, s[28:31], s59 offen lds
    s_waitcnt vmcnt(8)
    s_barrier
    s_bfe_u32 s59, s47, 262148
    s_add_u32 m0, s55, 131072
    s_lshl_b32 s59, s59, 17
    buffer_load_dwordx4 v12, s[28:31], s59 offen lds
    s_add_u32 m0, s55, 135168
    s_add_u32 s59, s59, 32768
    buffer_load_dwordx4 v12, s[28:31], s59 offen lds
    s_add_u32 m0, s55, 139264
    s_add_u32 s59, s59, 32768
    buffer_load_dwordx4 v12, s[28:31], s59 offen lds
    s_add_u32 m0, s55, 143360
    s_add_u32 s59, s59, 32768
    buffer_load_dwordx4 v12, s[28:31], s59 offen lds
    s_waitcnt vmcnt(8)
    s_barrier
    s_waitcnt vmcnt(7)
    s_bfe_u32 s59, s47, 262152
    s_add_u32 m0, s55, 0
    s_lshl_b32 s59, s59, 17
    buffer_load_dwordx4 v12, s[28:31], s59 offen lds
    s_waitcnt vmcnt(7)
    s_add_u32 m0, s55, 4096
    s_add_u32 s59, s59, 32768
    buffer_load_dwordx4 v12, s[28:31], s59 offen lds
    s_waitcnt vmcnt(7)
    s_add_u32 m0, s55, 8192
    s_add_u32 s59, s59, 32768
    buffer_load_dwordx4 v12, s[28:31], s59 offen lds
    s_waitcnt vmcnt(7)
    s_add_u32 m0, s55, 12288
    s_add_u32 s59, s59, 32768
    buffer_load_dwordx4 v12, s[28:31], s59 offen lds
    s_waitcnt vmcnt(7)
    s_bfe_u32 s59, s47, 262156
    s_add_u32 m0, s55, 16384
    s_lshl_b32 s59, s59, 17
    buffer_load_dwordx4 v12, s[28:31], s59 offen lds
    s_waitcnt vmcnt(7)
    s_add_u32 m0, s55, 20480
    s_add_u32 s59, s59, 32768
    buffer_load_dwordx4 v12, s[28:31], s59 offen lds
    s_waitcnt vmcnt(7)
    s_add_u32 m0, s55, 24576
    s_add_u32 s59, s59, 32768
    buffer_load_dwordx4 v12, s[28:31], s59 offen lds
    s_waitcnt vmcnt(7)
    s_add_u32 m0, s55, 28672
    s_add_u32 s59, s59, 32768
    buffer_load_dwordx4 v12, s[28:31], s59 offen lds
    s_waitcnt vmcnt(7)
    s_bfe_u32 s59, s47, 262160
    s_add_u32 m0, s55, 32768
    s_lshl_b32 s59, s59, 17
    buffer_load_dwordx4 v12, s[28:31], s59 offen lds
    s_waitcnt vmcnt(7)
    s_add_u32 m0, s55, 36864
    s_add_u32 s59, s59, 32768
    buffer_load_dwordx4 v12, s[28:31], s59 offen lds
    s_waitcnt vmcnt(7)
    s_add_u32 m0, s55, 40960
    s_add_u32 s59, s59, 32768
    buffer_load_dwordx4 v12, s[28:31], s59 offen lds
    s_waitcnt vmcnt(7)
    s_add_u32 m0, s55, 45056
    s_add_u32 s59, s59, 32768
    buffer_load_dwordx4 v12, s[28:31], s59 offen lds
    s_waitcnt vmcnt(7)
    s_bfe_u32 s59, s47, 262164
    s_add_u32 m0, s55, 49152
    s_lshl_b32 s59, s59, 17
    buffer_load_dwordx4 v12, s[28:31], s59 offen lds
    s_waitcnt vmcnt(7)
    s_add_u32 m0, s55, 53248
    s_add_u32 s59, s59, 32768
    buffer_load_dwordx4 v12, s[28:31], s59 offen lds
    s_waitcnt vmcnt(7)
    s_add_u32 m0, s55, 57344
    s_add_u32 s59, s59, 32768
    buffer_load_dwordx4 v12, s[28:31], s59 offen lds
    s_waitcnt vmcnt(7)
    s_add_u32 m0, s55, 61440
    s_add_u32 s59, s59, 32768
    buffer_load_dwordx4 v12, s[28:31], s59 offen lds
    s_waitcnt vmcnt(7)
    s_bfe_u32 s59, s47, 262168
    s_add_u32 m0, s55, 65536
    s_lshl_b32 s59, s59, 17
    buffer_load_dwordx4 v12, s[28:31], s59 offen lds
    s_waitcnt vmcnt(7)
    s_add_u32 m0, s55, 69632
    s_add_u32 s59, s59, 32768
    buffer_load_dwordx4 v12, s[28:31], s59 offen lds
    s_waitcnt vmcnt(7)
    s_add_u32 m0, s55, 73728
    s_add_u32 s59, s59, 32768
    buffer_load_dwordx4 v12, s[28:31], s59 offen lds
    s_waitcnt vmcnt(7)
    s_add_u32 m0, s55, 77824
    s_add_u32 s59, s59, 32768
    buffer_load_dwordx4 v12, s[28:31], s59 offen lds
    L_ld_a1:
    s_waitcnt vmcnt(12)
    s_barrier
    L_ld_a2:
    s_waitcnt vmcnt(0)
    s_barrier
    s_endpgm
    L_ld_P:
    s_mov_b32 s28, s10
    s_mov_b32 s29, s11
    s_mov_b32 s30, 7340032
    s_mov_b32 s31, 0x20000
    s_lshl_b32 s53, s52, 2
    v_add_u32 v5, s53, v3
    v_lshlrev_b32 v5, 1, v5
    v_xor_b32 v6, v5, v4
    v_lshlrev_b32 v6, 4, v6
    s_mul_i32 s53, s44, 448
    s_lshl_b32 s54, s3, 2
    s_add_u32 s53, s53, s54
    v_add_u32 v5, s53, v3
    v_lshlrev_b32 v5, 11, v5
    s_lshl_b32 s53, s48, 8
    v_add3_u32 v12, v5, v6, s53
    s_sub_u32 s54, s45, 14
    s_lshl_b32 s54, s54, 2
    s_add_u32 s54, s54, s3
    s_lshl_b32 s54, s54, 11
    v_lshl_add_u32 v9, v4, 7, s54
    v_min_u32 v9, 143232, v9
    s_mul_i32 s53, s44, 143360
    v_add_u32 v9, s53, v9
    global_load_dword v15, v9, s[16:17]
    s_bfe_u32 s59, s47, 262144
    s_add_u32 m0, s55, 114688
    s_lshl_b32 s59, s59, 17
    buffer_load_dwordx4 v12, s[28:31], s59 offen lds
    s_add_u32 m0, s55, 118784
    s_add_u32 s59, s59, 32768
    buffer_load_dwordx4 v12, s[28:31], s59 offen lds
    s_add_u32 m0, s55, 122880
    s_add_u32 s59, s59, 32768
    buffer_load_dwordx4 v12, s[28:31], s59 offen lds
    s_add_u32 m0, s55, 126976
    s_add_u32 s59, s59, 32768
    buffer_load_dwordx4 v12, s[28:31], s59 offen lds
    s_bfe_u32 s59, s47, 262148
    s_add_u32 m0, s55, 131072
    s_lshl_b32 s59, s59, 17
    buffer_load_dwordx4 v12, s[28:31], s59 offen lds
    s_add_u32 m0, s55, 135168
    s_add_u32 s59, s59, 32768
    buffer_load_dwordx4 v12, s[28:31], s59 offen lds
    s_add_u32 m0, s55, 139264
    s_add_u32 s59, s59, 32768
    buffer_load_dwordx4 v12, s[28:31], s59 offen lds
    s_add_u32 m0, s55, 143360
    s_add_u32 s59, s59, 32768
    buffer_load_dwordx4 v12, s[28:31], s59 offen lds
    s_bfe_u32 s59, s47, 262152
    s_add_u32 m0, s55, 0
    s_lshl_b32 s59, s59, 17
    buffer_load_dwordx4 v12, s[28:31], s59 offen lds
    s_add_u32 m0, s55, 4096
    s_add_u32 s59, s59, 32768
    buffer_load_dwordx4 v12, s[28:31], s59 offen lds
    s_add_u32 m0, s55, 8192
    s_add_u32 s59, s59, 32768
    buffer_load_dwordx4 v12, s[28:31], s59 offen lds
    s_add_u32 m0, s55, 12288
    s_add_u32 s59, s59, 32768
    buffer_load_dwordx4 v12, s[28:31], s59 offen lds
    s_bfe_u32 s59, s47, 262156
    s_add_u32 m0, s55, 16384
    s_lshl_b32 s59, s59, 17
    buffer_load_dwordx4 v12, s[28:31], s59 offen lds
    s_add_u32 m0, s55, 20480
    s_add_u32 s59, s59, 32768
    buffer_load_dwordx4 v12, s[28:31], s59 offen lds
    s_add_u32 m0, s55, 24576
    s_add_u32 s59, s59, 32768
    buffer_load_dwordx4 v12, s[28:31], s59 offen lds
    s_add_u32 m0, s55, 28672
    s_add_u32 s59, s59, 32768
    buffer_load_dwordx4 v12, s[28:31], s59 offen lds
    s_bfe_u32 s59, s47, 262160
    s_add_u32 m0, s55, 32768
    s_lshl_b32 s59, s59, 17
    buffer_load_dwordx4 v12, s[28:31], s59 offen lds
    s_add_u32 m0, s55, 36864
    s_add_u32 s59, s59, 32768
    buffer_load_dwordx4 v12, s[28:31], s59 offen lds
    s_add_u32 m0, s55, 40960
    s_add_u32 s59, s59, 32768
    buffer_load_dwordx4 v12, s[28:31], s59 offen lds
    s_add_u32 m0, s55, 45056
    s_add_u32 s59, s59, 32768
    buffer_load_dwordx4 v12, s[28:31], s59 offen lds
    s_bfe_u32 s59, s47, 262164
    s_add_u32 m0, s55, 49152
    s_lshl_b32 s59, s59, 17
    buffer_load_dwordx4 v12, s[28:31], s59 offen lds
    s_add_u32 m0, s55, 53248
    s_add_u32 s59, s59, 32768
    buffer_load_dwordx4 v12, s[28:31], s59 offen lds
    s_add_u32 m0, s55, 57344
    s_add_u32 s59, s59, 32768
    buffer_load_dwordx4 v12, s[28:31], s59 offen lds
    s_add_u32 m0, s55, 61440
    s_add_u32 s59, s59, 32768
    buffer_load_dwordx4 v12, s[28:31], s59 offen lds
    s_bfe_u32 s59, s47, 262168
    s_add_u32 m0, s55, 65536
    s_lshl_b32 s59, s59, 17
    buffer_load_dwordx4 v12, s[28:31], s59 offen lds
    s_add_u32 m0, s55, 69632
    s_add_u32 s59, s59, 32768
    buffer_load_dwordx4 v12, s[28:31], s59 offen lds
    s_add_u32 m0, s55, 73728
    s_add_u32 s59, s59, 32768
    buffer_load_dwordx4 v12, s[28:31], s59 offen lds
    s_add_u32 m0, s55, 77824
    s_add_u32 s59, s59, 32768
    buffer_load_dwordx4 v12, s[28:31], s59 offen lds
    s_branch L_ld_a1
    L_compute:
    s_sub_u32 s3, s3, 4
    s_and_b32 s50, s3, 1
    s_lshr_b32 s46, s3, 2
    s_lshl_b32 s51, s50, 1
    s_bfe_u32 s52, s3, 0x10001
    v_lshrrev_b32 v5, 2, v4
    v_and_b32 v6, 3, v2
    v_lshlrev_b32 v14, 4, v2
    v_lshlrev_b32 v16, 2, v2
    v_mov_b32 v15, 0
    s_mov_b32 s59, 4194304
    s_mov_b32 s34, 4214784
    s_mov_b32 s35, 0x20000
    s_mov_b32 s42, 256
    s_mov_b32 s43, 0x20000
    s_mov_b32 s38, 131072
    s_mov_b32 s39, 0x20000
    s_waitcnt lgkmcnt(0)
    s_mov_b32 s32, s16
    s_mov_b32 s33, s17
    s_mov_b32 s40, s14
    s_mov_b32 s41, s15
    s_add_u32 s90, s16, s59
    s_addc_u32 s91, s17, 0
    s_load_dword s87, s[90:91], 0
    s_mov_b32 s36, s12
    s_mov_b32 s37, s13
    s_getreg_b32 s100, hwreg(HW_REG_XCC_ID, 0, 16)
    s_lshl_b32 s100, s100, 16
    s_lshl_b32 s101, s44, 7
    s_add_u32 s101, s101, 4202496
    s_lshl_b32 s53, s45, 2
    v_mov_b32 v23, s53
    s_cmp_lt_u32 s45, 14
    s_cbranch_scc1 L_setup
    s_waitcnt lgkmcnt(0)
    s_mov_b64 exec, 1
    buffer_load_dword v21, v15, s[40:43], 0 offen sc1
    s_add_u32 s87, s87, 1
    s_and_b32 s87, s87, 0xffff
    s_cmp_lg_u32 s3, 0
    s_cbranch_scc1 L_norosn
    s_or_b32 s55, s100, s87
    v_mov_b32 v29, s55
    buffer_store_dword v29, v23, s[32:35], s101 offen
    L_norosn:
    s_mov_b64 exec, -1
    s_barrier
    L_setup:
    s_lshl_b32 s53, s44, 2
    s_add_u32 s53, s53, s51
    s_mul_i32 s53, s53, 7
    s_lshr_b32 s54, s45, 1
    s_add_u32 s53, s53, s54
    s_mul_i32 s53, s53, 5120
    s_and_b32 s54, s45, 1
    s_lshl_b32 s54, s54, 1
    s_add_u32 s54, s54, s52
    s_lshl_b32 s80, s54, 10
    s_add_u32 s80, s80, s53
    s_lshl_b32 s83, s54, 8
    s_add_u32 s83, s83, s53
    s_add_u32 s83, s83, 4096
    s_add_u32 s78, s80, 35840
    s_add_u32 s79, s83, 35840
    s_lshl_b32 s53, s3, 2
    s_lshr_b32 s53, s47, s53
    s_and_b32 s53, s53, 7
    s_lshl_b32 s54, s44, 2
    s_add_u32 s54, s54, s49
    s_mul_i32 s54, s54, 7
    s_add_u32 s53, s53, s54
    s_mul_i32 s81, s53, 5120
    s_add_u32 s82, s81, 4096
    v_lshlrev_b32 v9, 4, v4
    v_lshl_add_u32 v35, v3, 10, v9
    v_add_u32 v35, 12, v35
    s_lshl_b32 s53, s49, 3
    s_add_u32 s53, s53, s48
    s_lshl_b32 s98, s53, 7
    s_add_u32 s98, s98, 4210688
    s_add_u32 s28, s16, s98
    s_addc_u32 s29, s17, 0
    s_lshl_b32 s53, s53, 16
    s_add_u32 s53, s53, 2097152
    s_lshl_b32 s54, s44, 13
    s_add_u32 s57, s53, s54
    s_add_u32 s89, s57, 4096
    s_lshl_b32 s54, s46, 15
    s_add_u32 s53, s53, s54
    s_lshl_b32 s54, s44, 10
    s_add_u32 s53, s53, s54
    s_and_b32 s54, s3, 3
    s_lshl_b32 s54, s54, 8
    s_add_u32 s58, s53, s54
    v_lshlrev_b32 v18, 13, v3
    v_lshl_add_u32 v18, v4, 4, v18
    s_lshl_b32 s53, s44, 2
    v_mov_b32 v19, s53
    s_lshl_b32 s53, s49, 4
    s_and_b32 s54, s44, 3
    s_lshl_b32 s54, s54, 2
    s_add_u32 s53, s53, s54
    s_lshl_b32 s86, s53, 11
    s_lshl_b32 s53, s48, 8
    s_add_u32 s86, s86, s53
    s_lshr_b32 s54, s44, 2
    s_lshl_b32 s54, s54, 7
    s_add_u32 s86, s86, s54
    s_add_u32 s85, s86, 4096
    v_lshlrev_b32 v13, 1, v2
    v_lshl_add_u32 v7, v3, 2, v5
    v_and_b32 v9, 7, v7
    v_xor_b32 v9, s3, v9
    v_lshlrev_b32 v9, 5, v9
    v_lshlrev_b32 v7, 8, v7
    v_lshl_add_u32 v24, v6, 3, v7
    v_add_u32 v24, v24, v9
    v_add_u32 v25, 0x10000, v24
    v_add_u32 v26, 0x20000, v24
    s_lshl_b32 s53, s3, 11
    s_add_u32 s53, s53, 147456
    v_add_u32 v27, s53, v14
    v_add_u32 v28, 147456, v14
    v_lshl_add_u32 v7, v3, 3, v5
    v_lshlrev_b32 v7, 7, v7
    v_lshl_add_u32 v136, v6, 3, v7
    v_lshrrev_b32 v7, 1, v5
    v_and_b32 v9, 1, v3
    v_lshl_or_b32 v7, v9, 1, v7
    s_lshl_b32 s53, s52, 1
    v_xor_b32 v7, s53, v7
    v_lshl_add_u32 v136, v7, 5, v136
    v_add_u32 v137, 0x10000, v136
    v_add_u32 v138, 0x20000, v136
    v_xor_b32 v139, 32, v136
    v_add_u32 v140, 0x10000, v139
    v_add_u32 v141, 0x20000, v139
    v_lshrrev_b32 v7, 1, v4
    v_xor_b32 v7, v3, v7
    v_lshlrev_b32 v7, 4, v7
    s_lshl_b32 s53, s51, 11
    v_lshl_add_u32 v142, v4, 7, s53
    v_add_u32 v142, v142, v7
    v_add_u32 v143, 0x10000, v142
    v_add_u32 v144, 0x20000, v142
    v_xor_b32 v145, 64, v142
    v_add_u32 v146, 0x10000, v145
    v_add_u32 v147, 0x20000, v145
    v_and_b32 v22, 31, v2
    v_lshlrev_b32 v22, 2, v22
    s_cmp_ge_u32 s45, 14
    s_cbranch_scc1 L_c_P
    s_mov_b32 s53, 3222493025
    s_mov_b32 s54, 3184710632
    v_mov_b32 v8, s53
    v_mov_b32 v9, s53
    v_mov_b32 v30, s54
    v_mov_b32 v31, s54
    s_cmp_ge_u32 s3, 4
    s_cbranch_scc1 L_idle
    s_barrier
    ds_read_b64_tr_b16 v[40:41], v136 offset:0
    ds_read_b64_tr_b16 v[42:43], v136 offset:512
    ds_read_b128 v[56:59], v142 offset:8192
    ds_read_b128 v[60:63], v142 offset:10240
    ds_read_b64_tr_b16 v[44:45], v139 offset:0
    ds_read_b64_tr_b16 v[46:47], v139 offset:512
    ds_read_b64_tr_b16 v[48:49], v136 offset:4096
    ds_read_b64_tr_b16 v[50:51], v136 offset:4608
    ds_read_b128 v[64:67], v145 offset:8192
    ds_read_b128 v[68:71], v145 offset:10240
    ds_read_b64_tr_b16 v[52:53], v139 offset:4096
    ds_read_b64_tr_b16 v[54:55], v139 offset:4608
    s_waitcnt lgkmcnt(0)
    s_mov_b64 exec, 1
    buffer_load_dword v21, v15, s[40:43], 0 offen sc1
    s_add_u32 s87, s87, 1
    s_and_b32 s87, s87, 0xffff
    s_cmp_lg_u32 s3, 0
    s_cbranch_scc1 L_noros
    s_or_b32 s55, s100, s87
    v_mov_b32 v29, s55
    buffer_store_dword v29, v23, s[32:35], s101 offen
    L_noros:
    s_mov_b64 exec, -1
    s_waitcnt lgkmcnt(3)
    s_barrier
    ds_read_b64_tr_b16 v[72:73], v136 offset:16384
    ds_read_b64_tr_b16 v[74:75], v136 offset:16896
    ds_read_b128 v[88:91], v142 offset:24576
    ds_read_b128 v[92:95], v142 offset:26624
    ds_read_b64_tr_b16 v[76:77], v139 offset:16384
    ds_read_b64_tr_b16 v[78:79], v139 offset:16896
    ds_read_b64_tr_b16 v[80:81], v136 offset:20480
    ds_read_b64_tr_b16 v[82:83], v136 offset:20992
    ds_read_b128 v[96:99], v145 offset:24576
    ds_read_b128 v[100:103], v145 offset:26624
    ds_read_b64_tr_b16 v[84:85], v139 offset:20480
    ds_read_b64_tr_b16 v[86:87], v139 offset:20992
    v_mfma_f32_16x16x32_bf16 v[36:39], v[40:43], v[56:59], 0
    v_mfma_f32_16x16x32_bf16 v[152:155], v[40:43], v[60:63], 0
    v_mfma_f32_16x16x32_bf16 v[148:151], v[44:47], v[56:59], 0
    v_mfma_f32_16x16x32_bf16 v[156:159], v[44:47], v[60:63], 0
    v_mfma_f32_16x16x32_bf16 v[36:39], v[48:51], v[64:67], v[36:39]
    s_waitcnt lgkmcnt(12)
    v_mfma_f32_16x16x32_bf16 v[152:155], v[48:51], v[68:71], v[152:155]
    v_mfma_f32_16x16x32_bf16 v[148:151], v[52:55], v[64:67], v[148:151]
    v_mfma_f32_16x16x32_bf16 v[156:159], v[52:55], v[68:71], v[156:159]
    s_waitcnt lgkmcnt(3)
    s_barrier
    ds_read_b64_tr_b16 v[40:41], v136 offset:32768
    ds_read_b64_tr_b16 v[42:43], v136 offset:33280
    ds_read_b128 v[56:59], v142 offset:40960
    ds_read_b128 v[60:63], v142 offset:43008
    ds_read_b64_tr_b16 v[44:45], v139 offset:32768
    ds_read_b64_tr_b16 v[46:47], v139 offset:33280
    ds_read_b64_tr_b16 v[48:49], v136 offset:36864
    ds_read_b64_tr_b16 v[50:51], v136 offset:37376
    ds_read_b128 v[64:67], v145 offset:40960
    ds_read_b128 v[68:71], v145 offset:43008
    ds_read_b64_tr_b16 v[52:53], v139 offset:36864
    ds_read_b64_tr_b16 v[54:55], v139 offset:37376
    v_mfma_f32_16x16x32_bf16 v[36:39], v[72:75], v[88:91], v[36:39]
    v_mfma_f32_16x16x32_bf16 v[152:155], v[72:75], v[92:95], v[152:155]
    v_mfma_f32_16x16x32_bf16 v[148:151], v[76:79], v[88:91], v[148:151]
    v_mfma_f32_16x16x32_bf16 v[156:159], v[76:79], v[92:95], v[156:159]
    v_mfma_f32_16x16x32_bf16 v[36:39], v[80:83], v[96:99], v[36:39]
    s_waitcnt lgkmcnt(12)
    v_mfma_f32_16x16x32_bf16 v[152:155], v[80:83], v[100:103], v[152:155]
    v_mfma_f32_16x16x32_bf16 v[148:151], v[84:87], v[96:99], v[148:151]
    v_mfma_f32_16x16x32_bf16 v[156:159], v[84:87], v[100:103], v[156:159]
    s_waitcnt lgkmcnt(3)
    s_barrier
    ds_read_b64_tr_b16 v[72:73], v136 offset:49152
    ds_read_b64_tr_b16 v[74:75], v136 offset:49664
    ds_read_b128 v[88:91], v142 offset:57344
    ds_read_b128 v[92:95], v142 offset:59392
    ds_read_b64_tr_b16 v[76:77], v139 offset:49152
    ds_read_b64_tr_b16 v[78:79], v139 offset:49664
    ds_read_b64_tr_b16 v[80:81], v136 offset:53248
    ds_read_b64_tr_b16 v[82:83], v136 offset:53760
    ds_read_b128 v[96:99], v145 offset:57344
    ds_read_b128 v[100:103], v145 offset:59392
    ds_read_b64_tr_b16 v[84:85], v139 offset:53248
    ds_read_b64_tr_b16 v[86:87], v139 offset:53760
    v_mfma_f32_16x16x32_bf16 v[36:39], v[40:43], v[56:59], v[36:39]
    v_mfma_f32_16x16x32_bf16 v[152:155], v[40:43], v[60:63], v[152:155]
    v_mfma_f32_16x16x32_bf16 v[148:151], v[44:47], v[56:59], v[148:151]
    v_mfma_f32_16x16x32_bf16 v[156:159], v[44:47], v[60:63], v[156:159]
    v_mfma_f32_16x16x32_bf16 v[36:39], v[48:51], v[64:67], v[36:39]
    s_waitcnt lgkmcnt(12)
    v_mfma_f32_16x16x32_bf16 v[152:155], v[48:51], v[68:71], v[152:155]
    v_mfma_f32_16x16x32_bf16 v[148:151], v[52:55], v[64:67], v[148:151]
    v_mfma_f32_16x16x32_bf16 v[156:159], v[52:55], v[68:71], v[156:159]
    s_waitcnt lgkmcnt(3)
    s_barrier
    ds_read_b64_tr_b16 v[40:41], v137 offset:0
    ds_read_b64_tr_b16 v[42:43], v137 offset:512
    ds_read_b128 v[56:59], v143 offset:8192
    ds_read_b128 v[60:63], v143 offset:10240
    ds_read_b64_tr_b16 v[44:45], v140 offset:0
    ds_read_b64_tr_b16 v[46:47], v140 offset:512
    ds_read_b64_tr_b16 v[48:49], v137 offset:4096
    ds_read_b64_tr_b16 v[50:51], v137 offset:4608
    ds_read_b128 v[64:67], v146 offset:8192
    ds_read_b128 v[68:71], v146 offset:10240
    ds_read_b64_tr_b16 v[52:53], v140 offset:4096
    ds_read_b64_tr_b16 v[54:55], v140 offset:4608
    v_mfma_f32_16x16x32_bf16 v[36:39], v[72:75], v[88:91], v[36:39]
    v_mfma_f32_16x16x32_bf16 v[152:155], v[72:75], v[92:95], v[152:155]
    v_mfma_f32_16x16x32_bf16 v[148:151], v[76:79], v[88:91], v[148:151]
    v_mfma_f32_16x16x32_bf16 v[156:159], v[76:79], v[92:95], v[156:159]
    v_mfma_f32_16x16x32_bf16 v[36:39], v[80:83], v[96:99], v[36:39]
    s_waitcnt lgkmcnt(12)
    v_mfma_f32_16x16x32_bf16 v[152:155], v[80:83], v[100:103], v[152:155]
    v_mfma_f32_16x16x32_bf16 v[148:151], v[84:87], v[96:99], v[148:151]
    v_mfma_f32_16x16x32_bf16 v[156:159], v[84:87], v[100:103], v[156:159]
    s_waitcnt vmcnt(0)
    v_readfirstlane_b32 s55, v21
    s_nop 1
    s_cmp_lg_u32 s55, 0
    s_cselect_b32 s55, s55, s87
    s_and_b32 s55, s55, 0xffff
    s_or_b32 s100, s100, s55
    s_cmp_eq_u32 s55, s87
    s_cbranch_scc1 L_rok
    s_cmp_lg_u32 s3, 0
    s_cbranch_scc1 L_rok
    s_mov_b64 exec, 1
    v_mov_b32 v29, s100
    buffer_store_dword v29, v23, s[32:35], s101 offen
    s_mov_b64 exec, -1
    L_rok:
    s_mov_b32 s87, s55
    s_and_b32 s88, s87, 0xff
    s_waitcnt lgkmcnt(3)
    s_barrier
    ds_read_b64_tr_b16 v[72:73], v137 offset:16384
    ds_read_b64_tr_b16 v[74:75], v137 offset:16896
    ds_read_b128 v[88:91], v143 offset:24576
    ds_read_b128 v[92:95], v143 offset:26624
    ds_read_b64_tr_b16 v[76:77], v140 offset:16384
    ds_read_b64_tr_b16 v[78:79], v140 offset:16896
    ds_read_b64_tr_b16 v[80:81], v137 offset:20480
    ds_read_b64_tr_b16 v[82:83], v137 offset:20992
    ds_read_b128 v[96:99], v146 offset:24576
    ds_read_b128 v[100:103], v146 offset:26624
    ds_read_b64_tr_b16 v[84:85], v140 offset:20480
    ds_read_b64_tr_b16 v[86:87], v140 offset:20992
    v_mfma_f32_16x16x32_bf16 v[36:39], v[40:43], v[56:59], v[36:39]
    v_mfma_f32_16x16x32_bf16 v[152:155], v[40:43], v[60:63], v[152:155]
    v_mfma_f32_16x16x32_bf16 v[148:151], v[44:47], v[56:59], v[148:151]
    v_mfma_f32_16x16x32_bf16 v[156:159], v[44:47], v[60:63], v[156:159]
    v_mfma_f32_16x16x32_bf16 v[36:39], v[48:51], v[64:67], v[36:39]
    s_waitcnt lgkmcnt(12)
    v_mfma_f32_16x16x32_bf16 v[152:155], v[48:51], v[68:71], v[152:155]
    v_mfma_f32_16x16x32_bf16 v[148:151], v[52:55], v[64:67], v[148:151]
    v_mfma_f32_16x16x32_bf16 v[156:159], v[52:55], v[68:71], v[156:159]
    s_waitcnt lgkmcnt(3)
    s_barrier
    ds_read_b64_tr_b16 v[40:41], v137 offset:32768
    ds_read_b64_tr_b16 v[42:43], v137 offset:33280
    ds_read_b128 v[56:59], v143 offset:40960
    ds_read_b128 v[60:63], v143 offset:43008
    ds_read_b64_tr_b16 v[44:45], v140 offset:32768
    ds_read_b64_tr_b16 v[46:47], v140 offset:33280
    ds_read_b64_tr_b16 v[48:49], v137 offset:36864
    ds_read_b64_tr_b16 v[50:51], v137 offset:37376
    ds_read_b128 v[64:67], v146 offset:40960
    ds_read_b128 v[68:71], v146 offset:43008
    ds_read_b64_tr_b16 v[52:53], v140 offset:36864
    ds_read_b64_tr_b16 v[54:55], v140 offset:37376
    v_mfma_f32_16x16x32_bf16 v[36:39], v[72:75], v[88:91], v[36:39]
    v_mfma_f32_16x16x32_bf16 v[152:155], v[72:75], v[92:95], v[152:155]
    v_mfma_f32_16x16x32_bf16 v[148:151], v[76:79], v[88:91], v[148:151]
    v_mfma_f32_16x16x32_bf16 v[156:159], v[76:79], v[92:95], v[156:159]
    v_mfma_f32_16x16x32_bf16 v[36:39], v[80:83], v[96:99], v[36:39]
    s_waitcnt lgkmcnt(12)
    v_mfma_f32_16x16x32_bf16 v[152:155], v[80:83], v[100:103], v[152:155]
    v_mfma_f32_16x16x32_bf16 v[148:151], v[84:87], v[96:99], v[148:151]
    v_mfma_f32_16x16x32_bf16 v[156:159], v[84:87], v[100:103], v[156:159]
    s_waitcnt lgkmcnt(3)
    s_barrier
    ds_read_b64_tr_b16 v[72:73], v137 offset:49152
    ds_read_b64_tr_b16 v[74:75], v137 offset:49664
    ds_read_b128 v[88:91], v143 offset:57344
    ds_read_b128 v[92:95], v143 offset:59392
    ds_read_b64_tr_b16 v[76:77], v140 offset:49152
    ds_read_b64_tr_b16 v[78:79], v140 offset:49664
    ds_read_b64_tr_b16 v[80:81], v137 offset:53248
    ds_read_b64_tr_b16 v[82:83], v137 offset:53760
    ds_read_b128 v[96:99], v146 offset:57344
    ds_read_b128 v[100:103], v146 offset:59392
    ds_read_b64_tr_b16 v[84:85], v140 offset:53248
    ds_read_b64_tr_b16 v[86:87], v140 offset:53760
    v_mfma_f32_16x16x32_bf16 v[36:39], v[40:43], v[56:59], v[36:39]
    v_mfma_f32_16x16x32_bf16 v[152:155], v[40:43], v[60:63], v[152:155]
    v_mfma_f32_16x16x32_bf16 v[148:151], v[44:47], v[56:59], v[148:151]
    v_mfma_f32_16x16x32_bf16 v[156:159], v[44:47], v[60:63], v[156:159]
    v_mfma_f32_16x16x32_bf16 v[36:39], v[48:51], v[64:67], v[36:39]
    s_waitcnt lgkmcnt(12)
    v_mfma_f32_16x16x32_bf16 v[152:155], v[48:51], v[68:71], v[152:155]
    v_mfma_f32_16x16x32_bf16 v[148:151], v[52:55], v[64:67], v[148:151]
    v_mfma_f32_16x16x32_bf16 v[156:159], v[52:55], v[68:71], v[156:159]
    s_waitcnt lgkmcnt(3)
    s_barrier
    ds_read_b64_tr_b16 v[40:41], v138 offset:0
    ds_read_b64_tr_b16 v[42:43], v138 offset:512
    ds_read_b128 v[56:59], v144 offset:8192
    ds_read_b128 v[60:63], v144 offset:10240
    ds_read_b64_tr_b16 v[44:45], v141 offset:0
    ds_read_b64_tr_b16 v[46:47], v141 offset:512
    ds_read_b64_tr_b16 v[48:49], v138 offset:4096
    ds_read_b64_tr_b16 v[50:51], v138 offset:4608
    ds_read_b128 v[64:67], v147 offset:8192
    ds_read_b128 v[68:71], v147 offset:10240
    ds_read_b64_tr_b16 v[52:53], v141 offset:4096
    ds_read_b64_tr_b16 v[54:55], v141 offset:4608
    v_mfma_f32_16x16x32_bf16 v[36:39], v[72:75], v[88:91], v[36:39]
    v_mfma_f32_16x16x32_bf16 v[152:155], v[72:75], v[92:95], v[152:155]
    v_mfma_f32_16x16x32_bf16 v[148:151], v[76:79], v[88:91], v[148:151]
    v_mfma_f32_16x16x32_bf16 v[156:159], v[76:79], v[92:95], v[156:159]
    v_mfma_f32_16x16x32_bf16 v[36:39], v[80:83], v[96:99], v[36:39]
    s_waitcnt lgkmcnt(12)
    v_mfma_f32_16x16x32_bf16 v[152:155], v[80:83], v[100:103], v[152:155]
    v_mfma_f32_16x16x32_bf16 v[148:151], v[84:87], v[96:99], v[148:151]
    v_mfma_f32_16x16x32_bf16 v[156:159], v[84:87], v[100:103], v[156:159]
    s_waitcnt lgkmcnt(3)
    s_barrier
    ds_read_b64_tr_b16 v[72:73], v136 offset:0
    ds_read_b64_tr_b16 v[74:75], v136 offset:512
    ds_read_b128 v[88:91], v142 offset:8192
    ds_read_b128 v[92:95], v142 offset:10240
    ds_read_b64_tr_b16 v[76:77], v139 offset:0
    ds_read_b64_tr_b16 v[78:79], v139 offset:512
    ds_read_b64_tr_b16 v[80:81], v136 offset:4096
    ds_read_b64_tr_b16 v[82:83], v136 offset:4608
    ds_read_b128 v[96:99], v145 offset:8192
    ds_read_b128 v[100:103], v145 offset:10240
    ds_read_b64_tr_b16 v[84:85], v139 offset:4096
    ds_read_b64_tr_b16 v[86:87], v139 offset:4608
    v_mfma_f32_16x16x32_bf16 v[36:39], v[40:43], v[56:59], v[36:39]
    v_mfma_f32_16x16x32_bf16 v[152:155], v[40:43], v[60:63], v[152:155]
    v_mfma_f32_16x16x32_bf16 v[148:151], v[44:47], v[56:59], v[148:151]
    v_mfma_f32_16x16x32_bf16 v[156:159], v[44:47], v[60:63], v[156:159]
    v_mfma_f32_16x16x32_bf16 v[36:39], v[48:51], v[64:67], v[36:39]
    s_waitcnt lgkmcnt(12)
    v_mfma_f32_16x16x32_bf16 v[152:155], v[48:51], v[68:71], v[152:155]
    v_mfma_f32_16x16x32_bf16 v[148:151], v[52:55], v[64:67], v[148:151]
    v_mfma_f32_16x16x32_bf16 v[156:159], v[52:55], v[68:71], v[156:159]
    buffer_load_dword v34, v22, s[32:35], s101 offen sc1
    s_waitcnt lgkmcnt(3)
    s_barrier
    ds_read_b64_tr_b16 v[40:41], v136 offset:16384
    ds_read_b64_tr_b16 v[42:43], v136 offset:16896
    ds_read_b128 v[56:59], v142 offset:24576
    ds_read_b128 v[60:63], v142 offset:26624
    ds_read_b64_tr_b16 v[44:45], v139 offset:16384
    ds_read_b64_tr_b16 v[46:47], v139 offset:16896
    ds_read_b64_tr_b16 v[48:49], v136 offset:20480
    ds_read_b64_tr_b16 v[50:51], v136 offset:20992
    ds_read_b128 v[64:67], v145 offset:24576
    ds_read_b128 v[68:71], v145 offset:26624
    ds_read_b64_tr_b16 v[52:53], v139 offset:20480
    ds_read_b64_tr_b16 v[54:55], v139 offset:20992
    v_mfma_f32_16x16x32_bf16 v[36:39], v[72:75], v[88:91], v[36:39]
    v_mfma_f32_16x16x32_bf16 v[152:155], v[72:75], v[92:95], v[152:155]
    v_mfma_f32_16x16x32_bf16 v[148:151], v[76:79], v[88:91], v[148:151]
    v_mfma_f32_16x16x32_bf16 v[156:159], v[76:79], v[92:95], v[156:159]
    v_mfma_f32_16x16x32_bf16 v[36:39], v[80:83], v[96:99], v[36:39]
    s_waitcnt lgkmcnt(12)
    v_mfma_f32_16x16x32_bf16 v[152:155], v[80:83], v[100:103], v[152:155]
    v_mfma_f32_16x16x32_bf16 v[148:151], v[84:87], v[96:99], v[148:151]
    v_mfma_f32_16x16x32_bf16 v[156:159], v[84:87], v[100:103], v[156:159]
    s_waitcnt lgkmcnt(3)
    s_barrier
    ds_read_b64_tr_b16 v[72:73], v136 offset:32768
    ds_read_b64_tr_b16 v[74:75], v136 offset:33280
    ds_read_b128 v[88:91], v142 offset:40960
    ds_read_b128 v[92:95], v142 offset:43008
    ds_read_b64_tr_b16 v[76:77], v139 offset:32768
    ds_read_b64_tr_b16 v[78:79], v139 offset:33280
    ds_read_b64_tr_b16 v[80:81], v136 offset:36864
    ds_read_b64_tr_b16 v[82:83], v136 offset:37376
    ds_read_b128 v[96:99], v145 offset:40960
    ds_read_b128 v[100:103], v145 offset:43008
    ds_read_b64_tr_b16 v[84:85], v139 offset:36864
    ds_read_b64_tr_b16 v[86:87], v139 offset:37376
    v_mfma_f32_16x16x32_bf16 v[36:39], v[40:43], v[56:59], v[36:39]
    v_mfma_f32_16x16x32_bf16 v[152:155], v[40:43], v[60:63], v[152:155]
    v_mfma_f32_16x16x32_bf16 v[148:151], v[44:47], v[56:59], v[148:151]
    v_mfma_f32_16x16x32_bf16 v[156:159], v[44:47], v[60:63], v[156:159]
    v_mfma_f32_16x16x32_bf16 v[36:39], v[48:51], v[64:67], v[36:39]
    s_waitcnt lgkmcnt(12)
    v_mfma_f32_16x16x32_bf16 v[152:155], v[48:51], v[68:71], v[152:155]
    v_mfma_f32_16x16x32_bf16 v[148:151], v[52:55], v[64:67], v[148:151]
    v_mfma_f32_16x16x32_bf16 v[156:159], v[52:55], v[68:71], v[156:159]
    s_waitcnt lgkmcnt(3)
    s_barrier
    ds_read_b64_tr_b16 v[40:41], v136 offset:49152
    ds_read_b64_tr_b16 v[42:43], v136 offset:49664
    ds_read_b128 v[56:59], v142 offset:57344
    ds_read_b128 v[60:63], v142 offset:59392
    ds_read_b64_tr_b16 v[44:45], v139 offset:49152
    ds_read_b64_tr_b16 v[46:47], v139 offset:49664
    ds_read_b64_tr_b16 v[48:49], v136 offset:53248
    ds_read_b64_tr_b16 v[50:51], v136 offset:53760
    ds_read_b128 v[64:67], v145 offset:57344
    ds_read_b128 v[68:71], v145 offset:59392
    ds_read_b64_tr_b16 v[52:53], v139 offset:53248
    ds_read_b64_tr_b16 v[54:55], v139 offset:53760
    v_mfma_f32_16x16x32_bf16 v[36:39], v[72:75], v[88:91], v[36:39]
    v_mfma_f32_16x16x32_bf16 v[152:155], v[72:75], v[92:95], v[152:155]
    v_mfma_f32_16x16x32_bf16 v[148:151], v[76:79], v[88:91], v[148:151]
    v_mfma_f32_16x16x32_bf16 v[156:159], v[76:79], v[92:95], v[156:159]
    v_mfma_f32_16x16x32_bf16 v[36:39], v[80:83], v[96:99], v[36:39]
    s_waitcnt lgkmcnt(12)
    v_mfma_f32_16x16x32_bf16 v[152:155], v[80:83], v[100:103], v[152:155]
    v_mfma_f32_16x16x32_bf16 v[148:151], v[84:87], v[96:99], v[148:151]
    v_mfma_f32_16x16x32_bf16 v[156:159], v[84:87], v[100:103], v[156:159]
    s_waitcnt lgkmcnt(3)
    s_barrier
    ds_read_b64_tr_b16 v[72:73], v137 offset:0
    ds_read_b64_tr_b16 v[74:75], v137 offset:512
    ds_read_b128 v[88:91], v143 offset:8192
    ds_read_b128 v[92:95], v143 offset:10240
    ds_read_b64_tr_b16 v[76:77], v140 offset:0
    ds_read_b64_tr_b16 v[78:79], v140 offset:512
    ds_read_b64_tr_b16 v[80:81], v137 offset:4096
    ds_read_b64_tr_b16 v[82:83], v137 offset:4608
    ds_read_b128 v[96:99], v146 offset:8192
    ds_read_b128 v[100:103], v146 offset:10240
    ds_read_b64_tr_b16 v[84:85], v140 offset:4096
    ds_read_b64_tr_b16 v[86:87], v140 offset:4608
    v_mfma_f32_16x16x32_bf16 v[36:39], v[40:43], v[56:59], v[36:39]
    v_mfma_f32_16x16x32_bf16 v[152:155], v[40:43], v[60:63], v[152:155]
    v_mfma_f32_16x16x32_bf16 v[148:151], v[44:47], v[56:59], v[148:151]
    v_mfma_f32_16x16x32_bf16 v[156:159], v[44:47], v[60:63], v[156:159]
    v_mfma_f32_16x16x32_bf16 v[36:39], v[48:51], v[64:67], v[36:39]
    s_waitcnt lgkmcnt(12)
    v_mfma_f32_16x16x32_bf16 v[152:155], v[48:51], v[68:71], v[152:155]
    v_mfma_f32_16x16x32_bf16 v[148:151], v[52:55], v[64:67], v[148:151]
    v_mfma_f32_16x16x32_bf16 v[156:159], v[52:55], v[68:71], v[156:159]
    s_waitcnt vmcnt(0)
    v_cmp_ne_u32 s[18:19], s100, v34
    s_waitcnt lgkmcnt(3)
    s_barrier
    ds_read_b64_tr_b16 v[40:41], v137 offset:16384
    ds_read_b64_tr_b16 v[42:43], v137 offset:16896
    ds_read_b128 v[56:59], v143 offset:24576
    ds_read_b128 v[60:63], v143 offset:26624
    ds_read_b64_tr_b16 v[44:45], v140 offset:16384
    ds_read_b64_tr_b16 v[46:47], v140 offset:16896
    ds_read_b64_tr_b16 v[48:49], v137 offset:20480
    ds_read_b64_tr_b16 v[50:51], v137 offset:20992
    ds_read_b128 v[64:67], v146 offset:24576
    ds_read_b128 v[68:71], v146 offset:26624
    ds_read_b64_tr_b16 v[52:53], v140 offset:20480
    ds_read_b64_tr_b16 v[54:55], v140 offset:20992
    v_mfma_f32_16x16x32_bf16 v[36:39], v[72:75], v[88:91], v[36:39]
    v_mfma_f32_16x16x32_bf16 v[152:155], v[72:75], v[92:95], v[152:155]
    v_mfma_f32_16x16x32_bf16 v[148:151], v[76:79], v[88:91], v[148:151]
    v_mfma_f32_16x16x32_bf16 v[156:159], v[76:79], v[92:95], v[156:159]
    v_mfma_f32_16x16x32_bf16 v[36:39], v[80:83], v[96:99], v[36:39]
    s_waitcnt lgkmcnt(12)
    v_mfma_f32_16x16x32_bf16 v[152:155], v[80:83], v[100:103], v[152:155]
    v_mfma_f32_16x16x32_bf16 v[148:151], v[84:87], v[96:99], v[148:151]
    v_mfma_f32_16x16x32_bf16 v[156:159], v[84:87], v[100:103], v[156:159]
    s_waitcnt lgkmcnt(3)
    s_barrier
    s_setprio 3
    ds_read_b64_tr_b16 v[72:73], v137 offset:32768
    ds_read_b64_tr_b16 v[74:75], v137 offset:33280
    ds_read_b128 v[88:91], v143 offset:40960
    ds_read_b128 v[92:95], v143 offset:43008
    ds_read_b64_tr_b16 v[76:77], v140 offset:32768
    ds_read_b64_tr_b16 v[78:79], v140 offset:33280
    ds_read_b64_tr_b16 v[80:81], v137 offset:36864
    ds_read_b64_tr_b16 v[82:83], v137 offset:37376
    ds_read_b128 v[96:99], v146 offset:40960
    ds_read_b128 v[100:103], v146 offset:43008
    ds_read_b64_tr_b16 v[84:85], v140 offset:36864
    ds_read_b64_tr_b16 v[86:87], v140 offset:37376
    v_mfma_f32_16x16x32_bf16 v[36:39], v[40:43], v[56:59], v[36:39]
    v_mfma_f32_16x16x32_bf16 v[152:155], v[40:43], v[60:63], v[152:155]
    v_mfma_f32_16x16x32_bf16 v[148:151], v[44:47], v[56:59], v[148:151]
    v_mfma_f32_16x16x32_bf16 v[156:159], v[44:47], v[60:63], v[156:159]
    v_mfma_f32_16x16x32_bf16 v[36:39], v[48:51], v[64:67], v[36:39]
    s_waitcnt lgkmcnt(12)
    v_mfma_f32_16x16x32_bf16 v[152:155], v[48:51], v[68:71], v[152:155]
    v_mfma_f32_16x16x32_bf16 v[148:151], v[52:55], v[64:67], v[148:151]
    v_mfma_f32_16x16x32_bf16 v[156:159], v[52:55], v[68:71], v[156:159]
    s_waitcnt lgkmcnt(9)
    v_mfma_f32_16x16x32_bf16 v[36:39], v[72:75], v[88:91], v[36:39]
    s_waitcnt lgkmcnt(8)
    v_mfma_f32_16x16x32_bf16 v[152:155], v[72:75], v[92:95], v[152:155]
    s_waitcnt lgkmcnt(6)
    v_mfma_f32_16x16x32_bf16 v[148:151], v[76:79], v[88:91], v[148:151]
    v_mfma_f32_16x16x32_bf16 v[156:159], v[76:79], v[92:95], v[156:159]
    s_waitcnt lgkmcnt(3)
    v_mfma_f32_16x16x32_bf16 v[36:39], v[80:83], v[96:99], v[36:39]
    s_waitcnt lgkmcnt(2)
    v_mfma_f32_16x16x32_bf16 v[152:155], v[80:83], v[100:103], v[152:155]
    s_waitcnt lgkmcnt(0)
    v_mfma_f32_16x16x32_bf16 v[148:151], v[84:87], v[96:99], v[148:151]
    v_mfma_f32_16x16x32_bf16 v[156:159], v[84:87], v[100:103], v[156:159]
    s_bitcmp1_b32 s45, 0
    s_nop 5
    s_cbranch_scc1 L_st_up
    v_cvt_pk_bf16_f32 v44, 0, v36
    v_cvt_pk_bf16_f32 v45, 0, v37
    v_cvt_pk_bf16_f32 v46, 0, v38
    v_cvt_pk_bf16_f32 v47, 0, v39
    v_cvt_pk_bf16_f32 v48, 0, v148
    v_cvt_pk_bf16_f32 v49, 0, v149
    v_cvt_pk_bf16_f32 v50, 0, v150
    v_cvt_pk_bf16_f32 v51, 0, v151
    v_cvt_pk_bf16_f32 v52, 0, v152
    v_cvt_pk_bf16_f32 v53, 0, v153
    v_cvt_pk_bf16_f32 v54, 0, v154
    v_cvt_pk_bf16_f32 v55, 0, v155
    v_cvt_pk_bf16_f32 v56, 0, v156
    v_cvt_pk_bf16_f32 v57, 0, v157
    v_cvt_pk_bf16_f32 v58, 0, v158
    v_cvt_pk_bf16_f32 v59, 0, v159
    v_pk_mul_f32 v[60:61], v[44:45], v[44:45]
    v_pk_mul_f32 v[62:63], v[46:47], v[46:47]
    v_pk_mul_f32 v[64:65], v[48:49], v[48:49]
    v_pk_mul_f32 v[66:67], v[50:51], v[50:51]
    v_pk_mul_f32 v[68:69], v[52:53], v[52:53]
    v_pk_mul_f32 v[70:71], v[54:55], v[54:55]
    v_pk_mul_f32 v[72:73], v[56:57], v[56:57]
    v_pk_mul_f32 v[74:75], v[58:59], v[58:59]
    v_pk_fma_f32 v[60:61], v[60:61], v[30:31], v[8:9]
    v_pk_fma_f32 v[62:63], v[62:63], v[30:31], v[8:9]
    v_pk_fma_f32 v[64:65], v[64:65], v[30:31], v[8:9]
    v_pk_fma_f32 v[66:67], v[66:67], v[30:31], v[8:9]
    v_pk_fma_f32 v[68:69], v[68:69], v[30:31], v[8:9]
    v_pk_fma_f32 v[70:71], v[70:71], v[30:31], v[8:9]
    v_pk_fma_f32 v[72:73], v[72:73], v[30:31], v[8:9]
    v_pk_fma_f32 v[74:75], v[74:75], v[30:31], v[8:9]
    v_pk_mul_f32 v[60:61], v[60:61], v[44:45]
    v_pk_mul_f32 v[62:63], v[62:63], v[46:47]
    v_pk_mul_f32 v[64:65], v[64:65], v[48:49]
    v_pk_mul_f32 v[66:67], v[66:67], v[50:51]
    v_pk_mul_f32 v[68:69], v[68:69], v[52:53]
    v_pk_mul_f32 v[70:71], v[70:71], v[54:55]
    v_pk_mul_f32 v[72:73], v[72:73], v[56:57]
    v_pk_mul_f32 v[74:75], v[74:75], v[58:59]
    v_exp_f32 v60, v60
    v_exp_f32 v61, v61
    v_exp_f32 v62, v62
    v_exp_f32 v63, v63
    v_exp_f32 v64, v64
    v_exp_f32 v65, v65
    v_exp_f32 v66, v66
    v_exp_f32 v67, v67
    v_exp_f32 v68, v68
    v_exp_f32 v69, v69
    v_exp_f32 v70, v70
    v_exp_f32 v71, v71
    v_exp_f32 v72, v72
    v_exp_f32 v73, v73
    v_exp_f32 v74, v74
    v_exp_f32 v75, v75
    v_pk_add_f32 v[60:61], v[60:61], 1.0 op_sel_hi:[1,0]
    v_pk_add_f32 v[62:63], v[62:63], 1.0 op_sel_hi:[1,0]
    v_pk_add_f32 v[64:65], v[64:65], 1.0 op_sel_hi:[1,0]
    v_pk_add_f32 v[66:67], v[66:67], 1.0 op_sel_hi:[1,0]
    v_pk_add_f32 v[68:69], v[68:69], 1.0 op_sel_hi:[1,0]
    v_pk_add_f32 v[70:71], v[70:71], 1.0 op_sel_hi:[1,0]
    v_pk_add_f32 v[72:73], v[72:73], 1.0 op_sel_hi:[1,0]
    v_pk_add_f32 v[74:75], v[74:75], 1.0 op_sel_hi:[1,0]
    v_rcp_f32 v60, v60
    v_rcp_f32 v61, v61
    v_rcp_f32 v62, v62
    v_rcp_f32 v63, v63
    v_rcp_f32 v64, v64
    v_rcp_f32 v65, v65
    v_rcp_f32 v66, v66
    v_rcp_f32 v67, v67
    v_rcp_f32 v68, v68
    v_rcp_f32 v69, v69
    v_rcp_f32 v70, v70
    v_rcp_f32 v71, v71
    v_rcp_f32 v72, v72
    v_rcp_f32 v73, v73
    v_rcp_f32 v74, v74
    v_rcp_f32 v75, v75
    v_pk_mul_f32 v[36:37], v[44:45], v[60:61]
    v_pk_mul_f32 v[38:39], v[46:47], v[62:63]
    v_pk_mul_f32 v[148:149], v[48:49], v[64:65]
    v_pk_mul_f32 v[150:151], v[50:51], v[66:67]
    v_pk_mul_f32 v[152:153], v[52:53], v[68:69]
    v_pk_mul_f32 v[154:155], v[54:55], v[70:71]
    v_pk_mul_f32 v[156:157], v[56:57], v[72:73]
    v_pk_mul_f32 v[158:159], v[58:59], v[74:75]
    L_st_up:
    v_cvt_pk_bf16_f32 v44, v36, v37
    v_cvt_pk_bf16_f32 v45, v38, v39
    v_cvt_pk_bf16_f32 v46, v148, v149
    v_cvt_pk_bf16_f32 v47, 0, v150
    v_cvt_pk_bf16_f32 v52, 0, v151
    v_cvt_pk_bf16_f32 v48, v152, v153
    v_cvt_pk_bf16_f32 v49, v154, v155
    v_cvt_pk_bf16_f32 v50, v156, v157
    v_cvt_pk_bf16_f32 v51, 0, v158
    v_cvt_pk_bf16_f32 v53, 0, v159
    v_or_b32 v47, s87, v47
    v_or_b32 v52, s87, v52
    v_or_b32 v51, s87, v51
    v_or_b32 v53, s87, v53
    s_cmp_eq_u64 s[18:19], 0
    s_cbranch_scc1 L_st_plain
    buffer_store_dwordx4 v[44:47], v14, s[32:35], s80 offen sc1
    buffer_store_dword v52, v16, s[32:35], s83 offen sc1
    buffer_store_dwordx4 v[48:51], v14, s[32:35], s78 offen sc1
    buffer_store_dword v53, v16, s[32:35], s79 offen sc1
    s_branch L_p2
    L_st_plain:
    buffer_store_dwordx4 v[44:47], v14, s[32:35], s80 offen
    buffer_store_dword v52, v16, s[32:35], s83 offen
    buffer_store_dwordx4 v[48:51], v14, s[32:35], s78 offen
    buffer_store_dword v53, v16, s[32:35], s79 offen
    s_branch L_p2
    L_idle:
    s_barrier
    s_waitcnt lgkmcnt(0)
    s_mov_b64 exec, 1
    buffer_load_dword v21, v15, s[40:43], 0 offen sc1
    s_add_u32 s87, s87, 1
    s_and_b32 s87, s87, 0xffff
    s_cmp_lg_u32 s3, 0
    s_cbranch_scc1 L_norosi
    s_or_b32 s55, s100, s87
    v_mov_b32 v29, s55
    buffer_store_dword v29, v23, s[32:35], s101 offen
    L_norosi:
    s_mov_b64 exec, -1
    s_barrier
    s_barrier
    s_barrier
    s_barrier
    s_waitcnt vmcnt(0)
    v_readfirstlane_b32 s55, v21
    s_nop 1
    s_cmp_lg_u32 s55, 0
    s_cselect_b32 s55, s55, s87
    s_and_b32 s55, s55, 0xffff
    s_or_b32 s100, s100, s55
    s_cmp_eq_u32 s55, s87
    s_cbranch_scc1 L_roki
    s_cmp_lg_u32 s3, 0
    s_cbranch_scc1 L_roki
    s_mov_b64 exec, 1
    v_mov_b32 v29, s100
    buffer_store_dword v29, v23, s[32:35], s101 offen
    s_mov_b64 exec, -1
    L_roki:
    s_mov_b32 s87, s55
    s_and_b32 s88, s87, 0xff
    s_barrier
    s_barrier
    s_barrier
    s_barrier
    s_barrier
    s_barrier
    s_barrier
    s_barrier
    s_barrier
    s_barrier
    s_barrier
    s_setprio 3
    s_branch L_p2
    L_c_P:
    s_waitcnt vmcnt(0)
    v_readfirstlane_b32 s55, v21
    s_nop 1
    s_cmp_lg_u32 s55, 0
    s_cselect_b32 s55, s55, s87
    s_and_b32 s55, s55, 0xffff
    s_or_b32 s100, s100, s55
    s_cmp_eq_u32 s55, s87
    s_cbranch_scc1 L_rokn
    s_cmp_lg_u32 s3, 0
    s_cbranch_scc1 L_rokn
    s_mov_b64 exec, 1
    v_mov_b32 v29, s100
    buffer_store_dword v29, v23, s[32:35], s101 offen
    s_mov_b64 exec, -1
    L_rokn:
    s_mov_b32 s87, s55
    s_and_b32 s88, s87, 0xff
    s_add_u32 s53, s2, s3
    s_cmp_lg_u32 s53, 262
    s_cbranch_scc1 L_npb
    s_mov_b64 exec, 1
    v_mov_b32 v20, s87
    v_or_b32 v21, 0x10000, v20
    buffer_store_dword v21, v15, s[40:43], 0 offen sc1
    s_waitcnt vmcnt(0)
    buffer_store_dword v20, v15, s[32:35], s59 offen sc1
    s_mov_b64 exec, -1
    L_npb:
    s_setprio 3
    L_p2:
    s_mov_b32 s56, 0
    s_barrier
    s_cmp_eq_u32 s3, 7
    s_cbranch_scc1 L_w7
    buffer_load_dwordx4 v[60:63], v14, s[32:35], s81 offen offset:0 sc1
    buffer_load_dword v76, v16, s[32:35], s82 offen offset:0 sc1
    buffer_load_dwordx4 v[68:71], v14, s[32:35], s81 offen offset:2048 sc1
    buffer_load_dword v78, v16, s[32:35], s82 offen offset:512 sc1
    buffer_load_dwordx4 v[64:67], v14, s[32:35], s81 offen offset:1024 sc1
    buffer_load_dword v77, v16, s[32:35], s82 offen offset:256 sc1
    buffer_load_dwordx4 v[72:75], v14, s[32:35], s81 offen offset:3072 sc1
    buffer_load_dword v79, v16, s[32:35], s82 offen offset:768 sc1
    L_w7:
    ds_read_b64_tr_b16 v[80:81], v25 offset:49152
    ds_read_b64_tr_b16 v[82:83], v25 offset:53248
    ds_read_b64_tr_b16 v[84:85], v25 offset:57344
    ds_read_b64_tr_b16 v[86:87], v25 offset:61440
    ds_read_b64_tr_b16 v[88:89], v26 offset:0
    ds_read_b64_tr_b16 v[90:91], v26 offset:4096
    ds_read_b64_tr_b16 v[92:93], v26 offset:8192
    ds_read_b64_tr_b16 v[94:95], v26 offset:12288
    ds_read_b64_tr_b16 v[96:97], v24 offset:0
    ds_read_b64_tr_b16 v[98:99], v24 offset:4096
    ds_read_b64_tr_b16 v[100:101], v24 offset:8192
    ds_read_b64_tr_b16 v[102:103], v24 offset:12288
    s_waitcnt lgkmcnt(8)
    ds_read_b64_tr_b16 v[104:105], v24 offset:16384
    ds_read_b64_tr_b16 v[106:107], v24 offset:20480
    ds_read_b64_tr_b16 v[108:109], v24 offset:24576
    ds_read_b64_tr_b16 v[110:111], v24 offset:28672
    s_waitcnt lgkmcnt(0)
    s_barrier
    ds_read_b64_tr_b16 v[112:113], v24 offset:32768
    ds_read_b64_tr_b16 v[114:115], v24 offset:36864
    ds_read_b64_tr_b16 v[116:117], v24 offset:40960
    ds_read_b64_tr_b16 v[118:119], v24 offset:45056
    ds_read_b64_tr_b16 v[120:121], v24 offset:49152
    ds_read_b64_tr_b16 v[122:123], v24 offset:53248
    ds_read_b64_tr_b16 v[124:125], v24 offset:57344
    ds_read_b64_tr_b16 v[126:127], v24 offset:61440
    ds_read_b64_tr_b16 v[128:129], v25 offset:0
    ds_read_b64_tr_b16 v[130:131], v25 offset:4096
    ds_read_b64_tr_b16 v[132:133], v25 offset:8192
    ds_read_b64_tr_b16 v[134:135], v25 offset:12288
    s_cmp_eq_u32 s3, 7
    s_cbranch_scc1 L_hdone
    L_chk:
    s_waitcnt vmcnt(4)
    v_lshlrev_b32 v40, 16, v60
    v_and_b32 v41, 0xffff0000, v60
    v_lshlrev_b32 v42, 16, v61
    v_and_b32 v43, 0xffff0000, v61
    v_lshlrev_b32 v44, 16, v62
    v_and_b32 v45, 0xffff0000, v62
    v_xor_b32 v46, s87, v63
    v_xor_b32 v47, s87, v76
    v_lshlrev_b32 v48, 16, v68
    v_and_b32 v49, 0xffff0000, v68
    v_lshlrev_b32 v50, 16, v69
    v_and_b32 v51, 0xffff0000, v69
    v_lshlrev_b32 v52, 16, v70
    v_and_b32 v53, 0xffff0000, v70
    v_xor_b32 v54, s87, v71
    v_xor_b32 v55, s87, v78
    v_or3_b32 v7, v46, v47, v54
    v_or_b32 v7, v7, v55
    v_pk_mul_f32 v[40:41], v[40:41], v[48:49]
    v_pk_mul_f32 v[42:43], v[42:43], v[50:51]
    v_pk_mul_f32 v[44:45], v[44:45], v[52:53]
    v_pk_mul_f32 v[46:47], v[46:47], v[54:55]
    v_cvt_pk_bf16_f32 v56, v40, v41
    v_cvt_pk_bf16_f32 v57, v42, v43
    v_cvt_pk_bf16_f32 v58, v44, v45
    v_cvt_pk_bf16_f32 v59, v46, v47
    ds_write_b128 v27, v[56:59] offset:0
    s_waitcnt vmcnt(0)
    v_lshlrev_b32 v40, 16, v64
    v_and_b32 v41, 0xffff0000, v64
    v_lshlrev_b32 v42, 16, v65
    v_and_b32 v43, 0xffff0000, v65
    v_lshlrev_b32 v44, 16, v66
    v_and_b32 v45, 0xffff0000, v66
    v_xor_b32 v46, s87, v67
    v_xor_b32 v47, s87, v77
    v_lshlrev_b32 v48, 16, v72
    v_and_b32 v49, 0xffff0000, v72
    v_lshlrev_b32 v50, 16, v73
    v_and_b32 v51, 0xffff0000, v73
    v_lshlrev_b32 v52, 16, v74
    v_and_b32 v53, 0xffff0000, v74
    v_xor_b32 v54, s87, v75
    v_xor_b32 v55, s87, v79
    v_or3_b32 v7, v7, v46, v47
    v_or3_b32 v7, v7, v54, v55
    v_pk_mul_f32 v[40:41], v[40:41], v[48:49]
    v_pk_mul_f32 v[42:43], v[42:43], v[50:51]
    v_pk_mul_f32 v[44:45], v[44:45], v[52:53]
    v_pk_mul_f32 v[46:47], v[46:47], v[54:55]
    v_cvt_pk_bf16_f32 v152, v40, v41
    v_cvt_pk_bf16_f32 v153, v42, v43
    v_cvt_pk_bf16_f32 v154, v44, v45
    v_cvt_pk_bf16_f32 v155, v46, v47
    ds_write_b128 v27, v[152:155] offset:1024
    v_and_b32 v7, 0xffff, v7
    v_cmp_ne_u32 vcc, 0, v7
    s_add_u32 s56, s56, 1
    s_cmp_gt_u32 s56, 65536
    s_cbranch_scc1 L_hdone
    s_cbranch_vccz L_hdone
    s_cmp_le_u32 s56, 3
    s_cbranch_scc1 L_full
    L_hint:
    buffer_load_dword v17, v35, s[32:35], s81 offen sc1
    s_add_u32 s56, s56, 1
    s_cmp_gt_u32 s56, 65536
    s_cbranch_scc1 L_full
    s_waitcnt vmcnt(0)
    v_and_b32 v17, 0xffff, v17
    v_cmp_ne_u32 vcc, s87, v17
    s_cbranch_vccz L_full
    s_sleep 1
    s_branch L_hint
    L_full:
    s_waitcnt lgkmcnt(0)
    buffer_load_dwordx4 v[60:63], v14, s[32:35], s81 offen offset:0 sc1
    buffer_load_dword v76, v16, s[32:35], s82 offen offset:0 sc1
    buffer_load_dwordx4 v[68:71], v14, s[32:35], s81 offen offset:2048 sc1
    buffer_load_dword v78, v16, s[32:35], s82 offen offset:512 sc1
    buffer_load_dwordx4 v[64:67], v14, s[32:35], s81 offen offset:1024 sc1
    buffer_load_dword v77, v16, s[32:35], s82 offen offset:256 sc1
    buffer_load_dwordx4 v[72:75], v14, s[32:35], s81 offen offset:3072 sc1
    buffer_load_dword v79, v16, s[32:35], s82 offen offset:768 sc1
    s_branch L_chk
    L_hdone:
    s_waitcnt lgkmcnt(0)
    s_barrier
    s_cmp_lg_u32 s3, 7
    s_cbranch_scc1 L_nf
    v_mov_b32 v20, s87
    s_mov_b64 exec, 1
    buffer_store_dword v20, v19, s[32:35], s98 offen sc1
    s_mov_b64 exec, -1
    L_nf:
    ds_read_b128 v[40:43], v28 offset:0
    ds_read_b128 v[44:47], v28 offset:1024
    ds_read_b128 v[48:51], v28 offset:2048
    ds_read_b128 v[52:55], v28 offset:3072
    ds_read_b128 v[56:59], v28 offset:4096
    ds_read_b128 v[60:63], v28 offset:5120
    ds_read_b128 v[64:67], v28 offset:6144
    ds_read_b128 v[68:71], v28 offset:7168
    ds_read_b128 v[72:75], v28 offset:8192
    ds_read_b128 v[76:79], v28 offset:9216
    ds_read_b128 v[136:139], v28 offset:10240
    ds_read_b128 v[140:143], v28 offset:11264
    ds_read_b128 v[144:147], v28 offset:12288
    ds_read_b128 v[148:151], v28 offset:13312
    s_waitcnt lgkmcnt(13)
    v_mfma_f32_16x16x32_bf16 v[36:39], v[40:43], v[80:83], 0
    s_waitcnt lgkmcnt(12)
    v_mfma_f32_16x16x32_bf16 v[36:39], v[44:47], v[84:87], v[36:39]
    s_waitcnt lgkmcnt(11)
    v_mfma_f32_16x16x32_bf16 v[36:39], v[48:51], v[88:91], v[36:39]
    s_waitcnt lgkmcnt(10)
    v_mfma_f32_16x16x32_bf16 v[36:39], v[52:55], v[92:95], v[36:39]
    s_waitcnt lgkmcnt(9)
    v_mfma_f32_16x16x32_bf16 v[36:39], v[56:59], v[96:99], v[36:39]
    s_waitcnt lgkmcnt(8)
    v_mfma_f32_16x16x32_bf16 v[36:39], v[60:63], v[100:103], v[36:39]
    s_waitcnt lgkmcnt(7)
    v_mfma_f32_16x16x32_bf16 v[36:39], v[64:67], v[104:107], v[36:39]
    s_waitcnt lgkmcnt(6)
    v_mfma_f32_16x16x32_bf16 v[36:39], v[68:71], v[108:111], v[36:39]
    s_waitcnt lgkmcnt(5)
    v_mfma_f32_16x16x32_bf16 v[36:39], v[72:75], v[112:115], v[36:39]
    s_waitcnt lgkmcnt(4)
    v_mfma_f32_16x16x32_bf16 v[36:39], v[76:79], v[116:119], v[36:39]
    s_waitcnt lgkmcnt(3)
    v_mfma_f32_16x16x32_bf16 v[36:39], v[136:139], v[120:123], v[36:39]
    s_waitcnt lgkmcnt(2)
    v_mfma_f32_16x16x32_bf16 v[36:39], v[140:143], v[124:127], v[36:39]
    s_waitcnt lgkmcnt(1)
    v_mfma_f32_16x16x32_bf16 v[36:39], v[144:147], v[128:131], v[36:39]
    s_waitcnt lgkmcnt(0)
    v_mfma_f32_16x16x32_bf16 v[36:39], v[148:151], v[132:135], v[36:39]
    s_cmp_lg_u32 s3, 7
    s_movk_i32 s53, 0xff00
    v_mov_b32 v21, s88
    s_nop 5
    v_and_or_b32 v36, v36, s53, v21
    buffer_store_dwordx4 v[36:39], v18, s[32:35], s58 offen sc1
    s_cbranch_scc1 L_end
    s_mov_b32 s56, 0
    L_fpoll:
    s_load_dwordx8 s[4:11], s[28:29], 0 glc
    s_add_u32 s56, s56, 1
    s_cmp_gt_u32 s56, 65536
    s_waitcnt lgkmcnt(0)
    s_cbranch_scc1 L_rloop
    s_and_b64 s[20:21], s[4:5], s[6:7]
    s_or_b64 s[22:23], s[4:5], s[6:7]
    s_and_b64 s[20:21], s[20:21], s[8:9]
    s_or_b64 s[22:23], s[22:23], s[8:9]
    s_and_b64 s[20:21], s[20:21], s[10:11]
    s_or_b64 s[22:23], s[22:23], s[10:11]
    s_and_b32 s20, s20, s21
    s_or_b32 s22, s22, s23
    s_xor_b32 s20, s20, s87
    s_xor_b32 s22, s22, s87
    s_or_b32 s20, s20, s22
    s_cbranch_scc1 L_fpoll
    s_mov_b32 s56, 0
    L_rloop:
    buffer_load_dwordx4 v[40:43], v14, s[32:35], s57 offen offset:0 sc1
    buffer_load_dwordx4 v[44:47], v14, s[32:35], s57 offen offset:1024 sc1
    buffer_load_dwordx4 v[48:51], v14, s[32:35], s57 offen offset:2048 sc1
    buffer_load_dwordx4 v[52:55], v14, s[32:35], s57 offen offset:3072 sc1
    buffer_load_dwordx4 v[56:59], v14, s[32:35], s89 offen offset:0 sc1
    buffer_load_dwordx4 v[60:63], v14, s[32:35], s89 offen offset:1024 sc1
    buffer_load_dwordx4 v[64:67], v14, s[32:35], s89 offen offset:2048 sc1
    buffer_load_dwordx4 v[68:71], v14, s[32:35], s89 offen offset:3072 sc1
    v_mov_b32 v9, 0
    s_waitcnt vmcnt(7)
    v_xor_b32 v40, s88, v40
    v_or_b32 v9, v9, v40
    s_waitcnt vmcnt(6)
    v_xor_b32 v44, s88, v44
    v_or_b32 v9, v9, v44
    v_pk_add_f32 v[76:77], v[40:41], v[44:45]
    v_pk_add_f32 v[78:79], v[42:43], v[46:47]
    s_waitcnt vmcnt(5)
    v_xor_b32 v48, s88, v48
    v_or_b32 v9, v9, v48
    v_pk_add_f32 v[76:77], v[76:77], v[48:49]
    v_pk_add_f32 v[78:79], v[78:79], v[50:51]
    s_waitcnt vmcnt(4)
    v_xor_b32 v52, s88, v52
    v_or_b32 v9, v9, v52
    v_pk_add_f32 v[76:77], v[76:77], v[52:53]
    v_pk_add_f32 v[78:79], v[78:79], v[54:55]
    s_waitcnt vmcnt(3)
    v_xor_b32 v56, s88, v56
    v_or_b32 v9, v9, v56
    v_pk_add_f32 v[76:77], v[76:77], v[56:57]
    v_pk_add_f32 v[78:79], v[78:79], v[58:59]
    s_waitcnt vmcnt(2)
    v_xor_b32 v60, s88, v60
    v_or_b32 v9, v9, v60
    v_pk_add_f32 v[76:77], v[76:77], v[60:61]
    v_pk_add_f32 v[78:79], v[78:79], v[62:63]
    s_waitcnt vmcnt(1)
    v_xor_b32 v64, s88, v64
    v_or_b32 v9, v9, v64
    v_pk_add_f32 v[76:77], v[76:77], v[64:65]
    v_pk_add_f32 v[78:79], v[78:79], v[66:67]
    s_waitcnt vmcnt(0)
    v_xor_b32 v68, s88, v68
    v_or_b32 v9, v9, v68
    v_pk_add_f32 v[76:77], v[76:77], v[68:69]
    v_pk_add_f32 v[78:79], v[78:79], v[70:71]
    v_and_b32 v9, 0xff, v9
    v_cmp_ne_u32 vcc, 0, v9
    v_cvt_pk_bf16_f32 v74, v76, v77
    v_cvt_pk_bf16_f32 v75, v78, v79
    s_add_u32 s56, s56, 1
    s_cmp_gt_u32 s56, 131072
    s_cbranch_scc1 L_rgot
    s_cbranch_vccnz L_rloop
    L_rgot:
    buffer_store_short v74, v13, s[36:39], s86 offen
    buffer_store_short_d16_hi v74, v13, s[36:39], s86 offen offset:2048
    buffer_store_short v75, v13, s[36:39], s85 offen
    buffer_store_short_d16_hi v75, v13, s[36:39], s85 offen offset:2048
L_end:
    s_endpgm
.section .rodata,"a"
.p2align 6
.amdhsa_kernel standalone__geglu_ffn__sampling_kernel
  .amdhsa_next_free_vgpr 160
  .amdhsa_next_free_sgpr 102
  .amdhsa_accum_offset 160
  .amdhsa_group_segment_fixed_size 0
  .amdhsa_kernarg_size 56
  .amdhsa_user_sgpr_count 2
  .amdhsa_user_sgpr_kernarg_segment_ptr 1
  .amdhsa_system_sgpr_workgroup_id_x 1
  .amdhsa_float_denorm_mode_32 3
.end_amdhsa_kernel
```
